```python
import torch

def _softmax(x, axis=-1):
    return torch.softmax(x, dim=axis)
def _gelu(x):
    return torch.nn.functional.gelu(x, approximate="tanh")
def _silu(x):
    return torch.nn.functional.silu(x)
def _sigmoid(x):
    return torch.sigmoid(x)
def _layernorm(x, axis=-1, eps=1e-5):
    m = x.mean(dim=axis, keepdim=True)
    v = x.var(dim=axis, keepdim=True, unbiased=False)
    return (x - m) / torch.sqrt(v + eps)
def _scatter_add(tgt, idx, src, axis=0):
    return tgt.clone().index_add_(axis, idx, src)
def _segment_sum(src, seg, n):
    out = torch.zeros((n,) + src.shape[1:], dtype=src.dtype)
    return out.index_add_(0, seg, src)
def _pad(x, pw):
    flat = tuple(v for pair in reversed(pw) for v in pair)
    return torch.nn.functional.pad(x, flat)

kernel_name = 'standalone__spectral_conv_chebnet__graph'

def setup_inputs():

    _w = (lambda a: (lambda t: t.to(torch.bfloat16) if t.is_floating_point() else t)(torch.as_tensor(a)))
    N, deg, D, K = 50000, 16, 64, 2
    E = N * deg
    src = (lambda lo, hi, *s: torch.randint(lo, hi, s))(0, N, E).to(torch.int64)
    dst = (lambda lo, hi, *s: torch.randint(lo, hi, s))(0, N, E).to(torch.int64)
    deg_cnt = torch.bincount(dst, minlength=N).to(float) + 1.0
    dis = (1.0 / (lambda _x: torch.sqrt(torch.as_tensor(_x)))(deg_cnt)).to(float)
    ew = -(dis[src] * dis[dst])
    return {
        "x": _w((lambda *s: torch.randn(*s, dtype=torch.bfloat16) * 0.05)(N, D)),
        "src": _w(src),
        "dst": _w(dst),
        "ew": _w(ew),
        "w": _w((lambda *s: torch.randn(*s, dtype=torch.bfloat16) * 0.05)(K, D, D) * 0.2),
    }

def reference(x, src, dst, ew, w):
    N, K = x.shape[0], w.shape[0]
    Ts = [x]
    if K > 1:
        Ts.append(_segment_sum(ew[:, None] * x[src], dst, N))
    for k in range(2, K):
        Tk = 2.0 * _segment_sum(ew[:, None] * Ts[-1][src], dst, N) - Ts[-2]
        Ts.append(Tk)
    T = torch.stack(Ts, 0)
    return torch.einsum('knd,kde->ne', T, w)
```

```asm
; @launch kernel=k1_sort_kernel grid=(257,1,1) block=(1024,1,1) lds=26112
; @launch kernel=k4_main_kernel grid=(250,1,1) block=(1024,1,1) lds=146112
.amdgcn_target "amdgcn-amd-amdhsa--gfx950"
.text
.globl k1_sort_kernel
.p2align 8
.type k1_sort_kernel,@function
k1_sort_kernel:
  s_cmp_gt_u32 s2, 256
  s_cbranch_scc1 L_k1_end
  s_load_dwordx4 s[4:7], s[0:1], 8
  s_load_dwordx4 s[16:19], s[0:1], 24
  s_load_dwordx2 s[22:23], s[0:1], 56
  s_cmp_eq_u32 s2, 256
  s_cbranch_scc1 L_k1_wt
  v_lshlrev_b32 v1, 2, v0
  v_lshlrev_b32 v2, 1, v0
  v_mov_b32 v4, 0
  v_cmp_gt_u32 vcc, 256, v0
  s_and_saveexec_b64 s[20:21], vcc
  ds_write_b32 v1, v4
  s_mov_b64 exec, s[20:21]
  s_waitcnt lgkmcnt(0)
  s_mov_b32 s8, s4
  s_mov_b32 s9, s5
  s_mov_b32 s10, 3200000
  s_mov_b32 s11, 0x00020000
  s_mov_b32 s12, s6
  s_mov_b32 s13, s7
  s_mov_b32 s14, 3200000
  s_mov_b32 s15, 0x00020000
  s_mov_b32 s36, s16
  s_mov_b32 s37, s17
  s_mov_b32 s38, 1600000
  s_mov_b32 s39, 0x00020000
  s_mov_b32 s40, s22
  s_mov_b32 s41, s23
  s_mov_b32 s42, 7471104
  s_mov_b32 s43, 0x00020000
  s_mul_i32 s3, s2, 12500
  s_mul_i32 s44, s2, 6250
  s_add_u32 s24, s3, 0
  s_add_u32 s46, s44, 0
  s_add_u32 s25, s3, 4096
  s_add_u32 s47, s44, 2048
  s_add_u32 s26, s3, 8192
  s_add_u32 s48, s44, 4096
  s_add_u32 s27, s3, 12288
  s_add_u32 s49, s44, 6144
  v_cmp_gt_u32 vcc, 53, v0
  buffer_load_dword v10, v1, s[12:15], s24 offen
  buffer_load_dword v14, v1, s[8:11], s24 offen
  buffer_load_ushort v18, v2, s[36:39], s46 offen
  buffer_load_dword v11, v1, s[12:15], s25 offen
  buffer_load_dword v15, v1, s[8:11], s25 offen
  buffer_load_ushort v19, v2, s[36:39], s47 offen
  buffer_load_dword v12, v1, s[12:15], s26 offen
  buffer_load_dword v16, v1, s[8:11], s26 offen
  buffer_load_ushort v20, v2, s[36:39], s48 offen
  s_and_saveexec_b64 s[20:21], vcc
  buffer_load_dword v13, v1, s[12:15], s27 offen
  buffer_load_dword v17, v1, s[8:11], s27 offen
  buffer_load_ushort v21, v2, s[36:39], s49 offen
  s_mov_b64 exec, s[20:21]
  v_mov_b32 v3, 1
  s_barrier
  s_waitcnt vmcnt(11)
  v_mul_u32_u24 v4, 83887, v10
  v_lshrrev_b32 v4, 24, v4
  v_lshlrev_b32 v22, 2, v4
  ds_add_rtn_u32 v26, v22, v3 offset:0
  v_mul_u32_u24 v4, 200, v4
  v_sub_u32 v10, v10, v4
  s_waitcnt vmcnt(8)
  v_mul_u32_u24 v4, 83887, v11
  v_lshrrev_b32 v4, 24, v4
  v_lshlrev_b32 v23, 2, v4
  ds_add_rtn_u32 v27, v23, v3 offset:0
  v_mul_u32_u24 v4, 200, v4
  v_sub_u32 v11, v11, v4
  s_waitcnt vmcnt(5)
  v_mul_u32_u24 v4, 83887, v12
  v_lshrrev_b32 v4, 24, v4
  v_lshlrev_b32 v24, 2, v4
  ds_add_rtn_u32 v28, v24, v3 offset:0
  v_mul_u32_u24 v4, 200, v4
  v_sub_u32 v12, v12, v4
  s_and_saveexec_b64 s[20:21], vcc
  s_waitcnt vmcnt(2)
  v_mul_u32_u24 v4, 83887, v13
  v_lshrrev_b32 v4, 24, v4
  v_lshlrev_b32 v25, 2, v4
  ds_add_rtn_u32 v29, v25, v3 offset:0
  v_mul_u32_u24 v4, 200, v4
  v_sub_u32 v13, v13, v4
  s_mov_b64 exec, s[20:21]
  s_waitcnt lgkmcnt(0)
  s_barrier
  v_cmp_gt_u32 vcc, 64, v0
  s_and_saveexec_b64 s[20:21], vcc
  s_cbranch_execz L_k1_noscan
  v_lshlrev_b32 v4, 4, v0
  ds_read_b128 v[40:43], v4 offset:0
  v_mov_b32 v48, 0
  s_waitcnt lgkmcnt(0)
  v_add_u32 v49, v48, v40
  v_add_u32 v50, v49, v41
  v_add_u32 v51, v50, v42
  v_add_u32 v52, v51, v43
  v_mov_b32 v58, v52
  s_nop 1
  v_add_u32_dpp v58, v58, v58 row_shr:1 row_mask:0xf bank_mask:0xf bound_ctrl:0
  s_nop 1
  v_add_u32_dpp v58, v58, v58 row_shr:2 row_mask:0xf bank_mask:0xf bound_ctrl:0
  s_nop 1
  v_add_u32_dpp v58, v58, v58 row_shr:4 row_mask:0xf bank_mask:0xf bound_ctrl:0
  s_nop 1
  v_add_u32_dpp v58, v58, v58 row_shr:8 row_mask:0xf bank_mask:0xf bound_ctrl:0
  s_nop 1
  v_add_u32_dpp v58, v58, v58 row_bcast:15 row_mask:0xa bank_mask:0xf
  s_nop 1
  v_add_u32_dpp v58, v58, v58 row_bcast:31 row_mask:0xc bank_mask:0xf
  s_nop 1
  v_sub_u32 v58, v58, v52
  v_add_u32 v48, v48, v58
  v_add_u32 v49, v49, v58
  v_add_u32 v50, v50, v58
  v_add_u32 v51, v51, v58
  ds_write_b128 v4, v[48:51] offset:0
  v_lshl_or_b32 v52, v40, 16, v48
  v_lshl_or_b32 v53, v41, 16, v49
  v_lshl_or_b32 v54, v42, 16, v50
  v_lshl_or_b32 v55, v43, 16, v51
  v_lshlrev_b32 v4, 12, v0
  s_and_b32 s3, s2, 7
  s_lshl_b32 s3, s3, 5
  s_lshr_b32 s25, s2, 3
  s_add_u32 s3, s3, s25
  s_lshl_b32 s3, s3, 4
  buffer_store_dwordx4 v[52:55], v4, s[40:43], s3 offen
L_k1_noscan:
  s_mov_b64 exec, s[20:21]
  s_waitcnt lgkmcnt(0)
  s_barrier
  v_cmp_gt_u32 vcc, 53, v0
  ds_read_b32 v30, v22 offset:0
  ds_read_b32 v31, v23 offset:0
  ds_read_b32 v32, v24 offset:0
  s_and_saveexec_b64 s[20:21], vcc
  ds_read_b32 v33, v25 offset:0
  s_waitcnt vmcnt(0) lgkmcnt(0)
  v_add_u32 v4, v33, v29
  v_lshlrev_b32 v4, 3, v4
  v_lshl_or_b32 v41, v21, 16, v13
  v_mov_b32 v40, v17
  ds_write_b64 v4, v[40:41] offset:1024
  s_mov_b64 exec, s[20:21]
  v_add_u32 v4, v30, v26
  v_lshlrev_b32 v4, 3, v4
  v_lshl_or_b32 v35, v18, 16, v10
  v_mov_b32 v34, v14
  ds_write_b64 v4, v[34:35] offset:1024
  v_add_u32 v4, v31, v27
  v_lshlrev_b32 v4, 3, v4
  v_lshl_or_b32 v37, v19, 16, v11
  v_mov_b32 v36, v15
  ds_write_b64 v4, v[36:37] offset:1024
  v_add_u32 v4, v32, v28
  v_lshlrev_b32 v4, 3, v4
  v_lshl_or_b32 v39, v20, 16, v12
  v_mov_b32 v38, v16
  ds_write_b64 v4, v[38:39] offset:1024
  s_waitcnt lgkmcnt(0)
  s_barrier
  v_lshlrev_b32 v4, 4, v0
  s_mul_i32 s3, s2, 25088
  s_add_u32 s3, s3, 1048576
  s_add_u32 s24, s3, 16384
  ds_read_b128 v[40:43], v4 offset:1024
  v_cmp_gt_u32 vcc, 539, v0
  s_and_saveexec_b64 s[20:21], vcc
  ds_read_b128 v[44:47], v4 offset:17408
  s_waitcnt lgkmcnt(0)
  buffer_store_dwordx4 v[44:47], v4, s[40:43], s24 offen
  s_mov_b64 exec, s[20:21]
  buffer_store_dwordx4 v[40:43], v4, s[40:43], s3 offen
  s_endpgm
L_k1_wt:
  s_waitcnt lgkmcnt(0)
  s_mov_b32 s8, s18
  s_mov_b32 s9, s19
  s_mov_b32 s10, 16384
  s_mov_b32 s11, 0x00020000
  s_mov_b32 s12, s22
  s_mov_b32 s13, s23
  s_mov_b32 s14, 540672
  s_mov_b32 s15, 0x00020000
  v_lshrrev_b32 v4, 8, v0
  v_bfe_u32 v5, v0, 6, 2
  v_and_b32 v6, 15, v0
  v_bfe_u32 v7, v0, 4, 2
  v_lshrrev_b32 v8, 2, v6
  v_and_b32 v6, 3, v6
  v_lshl_add_u32 v6, v4, 2, v6
  v_lshl_add_u32 v6, v8, 4, v6
  v_lshlrev_b32 v5, 5, v5
  v_lshl_add_u32 v5, v7, 3, v5
  v_lshlrev_b32 v5, 7, v5
  v_lshl_add_u32 v5, v6, 1, v5
  buffer_load_ushort v10, v5, s[8:11], 0 offen offset:0
  buffer_load_ushort v11, v5, s[8:11], 0 offen offset:128
  buffer_load_ushort v12, v5, s[8:11], 0 offen offset:256
  buffer_load_ushort v13, v5, s[8:11], 0 offen offset:384
  buffer_load_ushort v14, v5, s[8:11], 0 offen offset:512
  buffer_load_ushort v15, v5, s[8:11], 0 offen offset:640
  buffer_load_ushort v16, v5, s[8:11], 0 offen offset:768
  buffer_load_ushort v17, v5, s[8:11], 0 offen offset:896
  s_waitcnt vmcnt(0)
  v_lshl_or_b32 v20, v11, 16, v10
  v_lshl_or_b32 v21, v13, 16, v12
  v_lshl_or_b32 v22, v15, 16, v14
  v_lshl_or_b32 v23, v17, 16, v16
  v_lshlrev_b32 v4, 4, v0
  s_mov_b32 s3, 524288
  buffer_store_dwordx4 v[20:23], v4, s[12:15], s3 offen
L_k1_end:
  s_endpgm
.globl k4_main_kernel
.p2align 8
.type k4_main_kernel,@function
k4_main_kernel:
  s_cmp_ge_u32 s2, 250
  s_cbranch_scc1 L_k4_end
  s_load_dwordx2 s[4:5], s[0:1], 0
  s_load_dwordx2 s[6:7], s[0:1], 40
  s_load_dwordx2 s[18:19], s[0:1], 56
  v_lshlrev_b32 v1, 4, v0
  v_lshrrev_b32 v4, 6, v0
  v_and_b32 v5, 63, v0
  s_mov_b32 s48, 0x01010101
  s_mov_b32 s49, 0x01010101
  v_readfirstlane_b32 s24, v4
  s_lshr_b32 s3, s2, 2
  s_lshl_b32 s3, s3, 12
  s_and_b32 s25, s2, 3
  s_lshl_b32 s25, s25, 2
  s_add_u32 s3, s3, s25
  v_lshrrev_b32 v6, 2, v0
  v_and_b32 v105, 31, v6
  v_lshrrev_b32 v7, 5, v6
  v_lshl_add_u32 v105, v105, 3, v7
  v_lshlrev_b32 v6, 4, v6
  s_waitcnt lgkmcnt(0)
  s_mov_b32 s44, s18
  s_mov_b32 s45, s19
  s_mov_b32 s46, 7471104
  s_mov_b32 s47, 0x00020000
  buffer_load_dword v101, v6, s[44:47], s3 offen
  s_mov_b32 s8, s4
  s_mov_b32 s9, s5
  s_mov_b32 s10, 6400000
  s_mov_b32 s11, 0x00020000
  s_mov_b32 s12, s6
  s_mov_b32 s13, s7
  s_mov_b32 s14, 6400000
  s_mov_b32 s15, 0x00020000
  v_and_b32 v9, 15, v5
  s_lshl_b32 s29, s24, 4
  v_add_u32 v9, s29, v9
  v_lshrrev_b32 v8, 4, v5
  s_mul_i32 s30, s2, 25600
  v_lshlrev_b32 v7, 7, v9
  v_lshl_add_u32 v114, v8, 4, v7
  v_cmp_gt_u32 vcc, 200, v9
  s_mov_b64 s[36:37], vcc
  v_mov_b32 v3, 0
  v_mov_b32 v6, 52488
  ds_write_b32 v6, v3
  v_and_b32 v6, 7, v5
  v_lshlrev_b32 v94, 5, v6
  v_lshlrev_b32 v93, 4, v6
  v_mov_b32 v95, 52480
  v_mov_b32 v96, 1
  v_add_u32 v99, 51200, v94
  v_and_b32 v103, 3, v0
  v_lshlrev_b32 v103, 1, v103
  v_mul_u32_u24 v104, 25088, v105
  v_lshl_add_u32 v104, v103, 3, v104
  s_mov_b32 s27, 0
  s_mov_b32 s26, 1048576
  s_mov_b32 s31, 0
  s_waitcnt vmcnt(0)
  v_lshrrev_b32 v102, 16, v101
  v_and_b32 v100, 0xffff, v101
  v_lshl_add_u32 v104, v100, 3, v104
L_k4_round:
  v_add_u32 v101, s27, v103
  v_add_u32 v6, 0, v101
  v_cmp_gt_u32 s[64:65], v102, v6
  v_add_u32 v6, 1, v101
  v_cmp_gt_u32 s[66:67], v102, v6
  s_mov_b64 exec, s[64:65]
  buffer_load_dwordx4 v[10:13], v104, s[44:47], s26 offen offset:0
  s_mov_b64 exec, -1
  v_add_u32 v6, 8, v101
  v_cmp_gt_u32 s[68:69], v102, v6
  v_add_u32 v6, 9, v101
  v_cmp_gt_u32 s[70:71], v102, v6
  s_mov_b64 exec, s[68:69]
  buffer_load_dwordx4 v[14:17], v104, s[44:47], s26 offen offset:64
  s_mov_b64 exec, -1
  v_add_u32 v6, 16, v101
  v_cmp_gt_u32 s[72:73], v102, v6
  v_add_u32 v6, 17, v101
  v_cmp_gt_u32 s[74:75], v102, v6
  s_mov_b64 exec, s[72:73]
  buffer_load_dwordx4 v[18:21], v104, s[44:47], s26 offen offset:128
  s_mov_b64 exec, -1
  v_add_u32 v6, 24, v101
  v_cmp_gt_u32 s[76:77], v102, v6
  v_add_u32 v6, 25, v101
  v_cmp_gt_u32 s[78:79], v102, v6
  s_mov_b64 exec, s[76:77]
  buffer_load_dwordx4 v[22:25], v104, s[44:47], s26 offen offset:192
  s_mov_b64 exec, -1
L_k4_iter:
  v_mov_b32 v6, 0x01000000
  v_mov_b32 v7, 0
  v_mov_b32 v8, 0x01000000
  v_mov_b32 v9, 0
  v_add_u32 v2, 52544, v1
  ds_write_b128 v2, v[6:9] offset:0
  ds_write_b128 v2, v[6:9] offset:16384
  ds_write_b128 v2, v[6:9] offset:32768
  ds_write_b128 v2, v[6:9] offset:49152
  v_cmp_gt_u32 vcc, 728, v0
  s_and_saveexec_b64 s[20:21], vcc
  v_add_u32 v2, 65536, v2
  ds_write_b128 v2, v[6:9]
  s_mov_b64 exec, s[20:21]
  v_cmp_gt_u32 vcc, 256, v0
  s_and_saveexec_b64 s[20:21], vcc
  v_lshlrev_b32 v6, 2, v0
  ds_write_b32 v6, v7 offset:51456
  ds_write_b32 v95, v7
  ds_write_b32 v95, v7 offset:12
  s_mov_b64 exec, s[20:21]
  s_waitcnt lgkmcnt(0)
  s_barrier
  s_mov_b32 s3, 524288
  buffer_load_dwordx4 v[116:119], v1, s[44:47], s3 offen
  s_mov_b64 exec, s[36:37]
  buffer_load_dwordx4 v[106:109], v114, s[8:11], s30 offen
  buffer_load_dwordx4 v[110:113], v114, s[8:11], s30 offen offset:64
  s_mov_b64 exec, -1
  v_cmp_lt_u32 vcc, 32, v102
  s_and_saveexec_b64 s[20:21], vcc
  ds_max_u32 v95, v102 offset:8
  s_mov_b64 exec, s[64:65]
  s_waitcnt vmcnt(6)
  v_and_b32 v6, 0xff, v11
  v_lshlrev_b32 v34, 2, v6
  ds_add_rtn_u32 v26, v34, v96 offset:51456
  s_mov_b64 exec, s[66:67]
  v_and_b32 v6, 0xff, v13
  v_lshlrev_b32 v35, 2, v6
  ds_add_rtn_u32 v27, v35, v96 offset:51456
  s_mov_b64 exec, s[68:69]
  s_waitcnt vmcnt(5)
  v_and_b32 v6, 0xff, v15
  v_lshlrev_b32 v36, 2, v6
  ds_add_rtn_u32 v28, v36, v96 offset:51456
  s_mov_b64 exec, s[70:71]
  v_and_b32 v6, 0xff, v17
  v_lshlrev_b32 v37, 2, v6
  ds_add_rtn_u32 v29, v37, v96 offset:51456
  s_or_b64 s[20:21], s[72:73], s[74:75]
  s_cbranch_scc0 L_k4_sh2
  s_mov_b64 exec, s[72:73]
  s_waitcnt vmcnt(4)
  v_and_b32 v6, 0xff, v19
  v_lshlrev_b32 v38, 2, v6
  ds_add_rtn_u32 v30, v38, v96 offset:51456
  s_mov_b64 exec, s[74:75]
  v_and_b32 v6, 0xff, v21
  v_lshlrev_b32 v39, 2, v6
  ds_add_rtn_u32 v31, v39, v96 offset:51456
L_k4_sh2:
  s_or_b64 s[20:21], s[76:77], s[78:79]
  s_cbranch_scc0 L_k4_sh3
  s_mov_b64 exec, s[76:77]
  s_waitcnt vmcnt(3)
  v_and_b32 v6, 0xff, v23
  v_lshlrev_b32 v40, 2, v6
  ds_add_rtn_u32 v32, v40, v96 offset:51456
  s_mov_b64 exec, s[78:79]
  v_and_b32 v6, 0xff, v25
  v_lshlrev_b32 v41, 2, v6
  ds_add_rtn_u32 v33, v41, v96 offset:51456
L_k4_sh3:
  s_waitcnt lgkmcnt(0)
  s_mov_b64 exec, s[64:65]
  v_cmp_gt_u32 vcc, 48, v26
  v_mul_u32_u24 v6, 96, v34
  v_lshl_add_u32 v6, v26, 3, v6
  v_mov_b32 v2, v10
  v_and_b32 v3, 0xffff0000, v11
  s_andn2_b64 s[64:65], s[64:65], vcc
  s_mov_b64 exec, vcc
  ds_write_b64 v6, v[2:3] offset:52544
  s_mov_b64 exec, s[66:67]
  v_cmp_gt_u32 vcc, 48, v27
  v_mul_u32_u24 v6, 96, v35
  v_lshl_add_u32 v6, v27, 3, v6
  v_mov_b32 v8, v12
  v_and_b32 v9, 0xffff0000, v13
  s_andn2_b64 s[66:67], s[66:67], vcc
  s_mov_b64 exec, vcc
  ds_write_b64 v6, v[8:9] offset:52544
  s_mov_b64 exec, s[68:69]
  v_cmp_gt_u32 vcc, 48, v28
  v_mul_u32_u24 v6, 96, v36
  v_lshl_add_u32 v6, v28, 3, v6
  v_mov_b32 v2, v14
  v_and_b32 v3, 0xffff0000, v15
  s_andn2_b64 s[68:69], s[68:69], vcc
  s_mov_b64 exec, vcc
  ds_write_b64 v6, v[2:3] offset:52544
  s_mov_b64 exec, s[70:71]
  v_cmp_gt_u32 vcc, 48, v29
  v_mul_u32_u24 v6, 96, v37
  v_lshl_add_u32 v6, v29, 3, v6
  v_mov_b32 v8, v16
  v_and_b32 v9, 0xffff0000, v17
  s_andn2_b64 s[70:71], s[70:71], vcc
  s_mov_b64 exec, vcc
  ds_write_b64 v6, v[8:9] offset:52544
  s_or_b64 s[20:21], s[72:73], s[74:75]
  s_cbranch_scc0 L_k4_ss2
  s_mov_b64 exec, s[72:73]
  v_cmp_gt_u32 vcc, 48, v30
  v_mul_u32_u24 v6, 96, v38
  v_lshl_add_u32 v6, v30, 3, v6
  v_mov_b32 v2, v18
  v_and_b32 v3, 0xffff0000, v19
  s_andn2_b64 s[72:73], s[72:73], vcc
  s_mov_b64 exec, vcc
  ds_write_b64 v6, v[2:3] offset:52544
  s_mov_b64 exec, s[74:75]
  v_cmp_gt_u32 vcc, 48, v31
  v_mul_u32_u24 v6, 96, v39
  v_lshl_add_u32 v6, v31, 3, v6
  v_mov_b32 v8, v20
  v_and_b32 v9, 0xffff0000, v21
  s_andn2_b64 s[74:75], s[74:75], vcc
  s_mov_b64 exec, vcc
  ds_write_b64 v6, v[8:9] offset:52544
L_k4_ss2:
  s_or_b64 s[20:21], s[76:77], s[78:79]
  s_cbranch_scc0 L_k4_ss3
  s_mov_b64 exec, s[76:77]
  v_cmp_gt_u32 vcc, 48, v32
  v_mul_u32_u24 v6, 96, v40
  v_lshl_add_u32 v6, v32, 3, v6
  v_mov_b32 v2, v22
  v_and_b32 v3, 0xffff0000, v23
  s_andn2_b64 s[76:77], s[76:77], vcc
  s_mov_b64 exec, vcc
  ds_write_b64 v6, v[2:3] offset:52544
  s_mov_b64 exec, s[78:79]
  v_cmp_gt_u32 vcc, 48, v33
  v_mul_u32_u24 v6, 96, v41
  v_lshl_add_u32 v6, v33, 3, v6
  v_mov_b32 v8, v24
  v_and_b32 v9, 0xffff0000, v25
  s_andn2_b64 s[78:79], s[78:79], vcc
  s_mov_b64 exec, vcc
  ds_write_b64 v6, v[8:9] offset:52544
L_k4_ss3:
  s_mov_b64 exec, -1
  s_or_b64 s[20:21], s[64:65], s[66:67]
  s_or_b64 s[20:21], s[20:21], s[68:69]
  s_or_b64 s[20:21], s[20:21], s[70:71]
  s_or_b64 s[20:21], s[20:21], s[72:73]
  s_or_b64 s[20:21], s[20:21], s[74:75]
  s_or_b64 s[20:21], s[20:21], s[76:77]
  s_or_b64 s[20:21], s[20:21], s[78:79]
  s_cbranch_scc0 L_k4_noovf
  ds_write_b32 v95, v96 offset:12
L_k4_noovf:
  s_waitcnt lgkmcnt(0)
  s_barrier
  ds_read_b64 v[100:101], v95 offset:8
  v_add_u32 v6, 129728, v1
  s_waitcnt vmcnt(2)
  ds_write_b128 v6, v[116:119]
  v_mov_b32 v88, 0
  v_mov_b32 v89, 0
  v_mov_b32 v80, 0
  v_mov_b32 v81, 0
  v_mov_b32 v82, 0
  v_mov_b32 v83, 0
  v_mov_b32 v84, 0
  v_mov_b32 v85, 0
  v_mov_b32 v86, 0
  v_mov_b32 v87, 0
  v_cmp_eq_u32 vcc, v88, v89
  s_and_saveexec_b64 s[20:21], vcc
  s_cbranch_execz L_k4_ng1
  s_mov_b64 s[54:55], exec
  s_and_b64 exec, exec, s[48:49]
  ds_add_rtn_u32 v97, v95, v96
  s_mov_b64 exec, s[54:55]
  s_waitcnt lgkmcnt(0)
  ds_swizzle_b32 v97, v97 offset:0x18
  s_waitcnt lgkmcnt(0)
  v_min_u32 v97, 200, v97
  v_lshlrev_b32 v98, 2, v97
  ds_read_b32 v89, v98 offset:51456
  v_mul_u32_u24 v88, 384, v97
  v_add_u32 v88, 52544, v88
  v_lshl_add_u32 v90, v97, 8, v94
  s_waitcnt lgkmcnt(0)
  v_min_u32 v89, 48, v89
  v_add_u32 v89, 3, v89
  v_and_b32 v89, -4, v89
  v_max_u32 v89, 4, v89
  v_lshl_add_u32 v89, v89, 3, v88
L_k4_ng1:
  s_mov_b64 exec, s[20:21]
  ds_read_b128 v[64:67], v88
  ds_read_b128 v[68:71], v88 offset:16
  v_add_u32 v88, 32, v88
  v_mov_b32 v91, v90
  v_cmp_eq_u32 s[50:51], v88, v89
  s_waitcnt lgkmcnt(1)
  v_lshl_add_u32 v97, v64, 7, v93
  buffer_load_dwordx4 v[32:35], v97, s[8:11], 0 offen
  v_lshl_add_u32 v98, v66, 7, v93
  buffer_load_dwordx4 v[36:39], v98, s[8:11], 0 offen
  s_waitcnt lgkmcnt(0)
  v_lshl_add_u32 v97, v68, 7, v93
  buffer_load_dwordx4 v[40:43], v97, s[8:11], 0 offen
  v_lshl_add_u32 v98, v70, 7, v93
  buffer_load_dwordx4 v[44:47], v98, s[8:11], 0 offen
L_k4_loop:
  v_cmp_eq_u32 vcc, v88, v89
  s_and_saveexec_b64 s[20:21], vcc
  s_cbranch_execz L_k4_ng2
  s_mov_b64 s[54:55], exec
  s_and_b64 exec, exec, s[48:49]
  ds_add_rtn_u32 v97, v95, v96
  s_mov_b64 exec, s[54:55]
  s_waitcnt lgkmcnt(0)
  ds_swizzle_b32 v97, v97 offset:0x18
  s_waitcnt lgkmcnt(0)
  v_min_u32 v97, 200, v97
  v_lshlrev_b32 v98, 2, v97
  ds_read_b32 v89, v98 offset:51456
  v_mul_u32_u24 v88, 384, v97
  v_add_u32 v88, 52544, v88
  v_lshl_add_u32 v90, v97, 8, v94
  s_waitcnt lgkmcnt(0)
  v_min_u32 v89, 48, v89
  v_add_u32 v89, 3, v89
  v_and_b32 v89, -4, v89
  v_max_u32 v89, 4, v89
  v_lshl_add_u32 v89, v89, 3, v88
L_k4_ng2:
  s_mov_b64 exec, s[20:21]
  ds_read_b128 v[72:75], v88
  ds_read_b128 v[76:79], v88 offset:16
  v_add_u32 v88, 32, v88
  v_mov_b32 v92, v90
  v_cmp_eq_u32 s[52:53], v88, v89
  s_waitcnt lgkmcnt(1)
  v_lshl_add_u32 v97, v72, 7, v93
  buffer_load_dwordx4 v[48:51], v97, s[8:11], 0 offen
  v_lshl_add_u32 v98, v74, 7, v93
  buffer_load_dwordx4 v[52:55], v98, s[8:11], 0 offen
  s_waitcnt lgkmcnt(0)
  v_lshl_add_u32 v97, v76, 7, v93
  buffer_load_dwordx4 v[56:59], v97, s[8:11], 0 offen
  v_lshl_add_u32 v98, v78, 7, v93
  buffer_load_dwordx4 v[60:63], v98, s[8:11], 0 offen
  v_lshrrev_b32 v97, 16, v65
  s_waitcnt vmcnt(7)
  v_dot2c_f32_bf16 v80, v32, v97
  v_dot2c_f32_bf16 v81, v32, v65
  v_dot2c_f32_bf16 v82, v33, v97
  v_dot2c_f32_bf16 v83, v33, v65
  v_dot2c_f32_bf16 v84, v34, v97
  v_dot2c_f32_bf16 v85, v34, v65
  v_dot2c_f32_bf16 v86, v35, v97
  v_dot2c_f32_bf16 v87, v35, v65
  v_lshrrev_b32 v98, 16, v67
  s_waitcnt vmcnt(6)
  v_dot2c_f32_bf16 v80, v36, v98
  v_dot2c_f32_bf16 v81, v36, v67
  v_dot2c_f32_bf16 v82, v37, v98
  v_dot2c_f32_bf16 v83, v37, v67
  v_dot2c_f32_bf16 v84, v38, v98
  v_dot2c_f32_bf16 v85, v38, v67
  v_dot2c_f32_bf16 v86, v39, v98
  v_dot2c_f32_bf16 v87, v39, v67
  v_lshrrev_b32 v97, 16, v69
  s_waitcnt vmcnt(5)
  v_dot2c_f32_bf16 v80, v40, v97
  v_dot2c_f32_bf16 v81, v40, v69
  v_dot2c_f32_bf16 v82, v41, v97
  v_dot2c_f32_bf16 v83, v41, v69
  v_dot2c_f32_bf16 v84, v42, v97
  v_dot2c_f32_bf16 v85, v42, v69
  v_dot2c_f32_bf16 v86, v43, v97
  v_dot2c_f32_bf16 v87, v43, v69
  v_lshrrev_b32 v98, 16, v71
  s_waitcnt vmcnt(4)
  v_dot2c_f32_bf16 v80, v44, v98
  v_dot2c_f32_bf16 v81, v44, v71
  v_dot2c_f32_bf16 v82, v45, v98
  v_dot2c_f32_bf16 v83, v45, v71
  v_dot2c_f32_bf16 v84, v46, v98
  v_dot2c_f32_bf16 v85, v46, v71
  v_dot2c_f32_bf16 v86, v47, v98
  v_dot2c_f32_bf16 v87, v47, v71
  s_and_saveexec_b64 s[20:21], s[50:51]
  s_cbranch_execz L_k4_nf3
  s_cmp_eq_u32 s31, 0
  s_cbranch_scc1 L_k4_dw3
  ds_read_b128 v[120:123], v91
  ds_read_b128 v[124:127], v91 offset:16
  s_waitcnt lgkmcnt(0)
  v_add_f32 v80, v120, v80
  v_add_f32 v81, v121, v81
  v_add_f32 v82, v122, v82
  v_add_f32 v83, v123, v83
  v_add_f32 v84, v124, v84
  v_add_f32 v85, v125, v85
  v_add_f32 v86, v126, v86
  v_add_f32 v87, v127, v87
L_k4_dw3:
  ds_write_b128 v91, v[80:83]
  ds_write_b128 v91, v[84:87] offset:16
  s_nop 1
  v_mov_b32 v80, 0
  v_mov_b32 v81, 0
  v_mov_b32 v82, 0
  v_mov_b32 v83, 0
  v_mov_b32 v84, 0
  v_mov_b32 v85, 0
  v_mov_b32 v86, 0
  v_mov_b32 v87, 0
L_k4_nf3:
  s_mov_b64 exec, s[20:21]
  v_cmp_ne_u32 vcc, v99, v92
  s_cbranch_vccz L_k4_gdone
  v_cmp_eq_u32 vcc, v88, v89
  s_and_saveexec_b64 s[20:21], vcc
  s_cbranch_execz L_k4_ng4
  s_mov_b64 s[54:55], exec
  s_and_b64 exec, exec, s[48:49]
  ds_add_rtn_u32 v97, v95, v96
  s_mov_b64 exec, s[54:55]
  s_waitcnt lgkmcnt(0)
  ds_swizzle_b32 v97, v97 offset:0x18
  s_waitcnt lgkmcnt(0)
  v_min_u32 v97, 200, v97
  v_lshlrev_b32 v98, 2, v97
  ds_read_b32 v89, v98 offset:51456
  v_mul_u32_u24 v88, 384, v97
  v_add_u32 v88, 52544, v88
  v_lshl_add_u32 v90, v97, 8, v94
  s_waitcnt lgkmcnt(0)
  v_min_u32 v89, 48, v89
  v_add_u32 v89, 3, v89
  v_and_b32 v89, -4, v89
  v_max_u32 v89, 4, v89
  v_lshl_add_u32 v89, v89, 3, v88
L_k4_ng4:
  s_mov_b64 exec, s[20:21]
  ds_read_b128 v[64:67], v88
  ds_read_b128 v[68:71], v88 offset:16
  v_add_u32 v88, 32, v88
  v_mov_b32 v91, v90
  v_cmp_eq_u32 s[50:51], v88, v89
  s_waitcnt lgkmcnt(1)
  v_lshl_add_u32 v97, v64, 7, v93
  buffer_load_dwordx4 v[32:35], v97, s[8:11], 0 offen
  v_lshl_add_u32 v98, v66, 7, v93
  buffer_load_dwordx4 v[36:39], v98, s[8:11], 0 offen
  s_waitcnt lgkmcnt(0)
  v_lshl_add_u32 v97, v68, 7, v93
  buffer_load_dwordx4 v[40:43], v97, s[8:11], 0 offen
  v_lshl_add_u32 v98, v70, 7, v93
  buffer_load_dwordx4 v[44:47], v98, s[8:11], 0 offen
  v_lshrrev_b32 v97, 16, v73
  s_waitcnt vmcnt(7)
  v_dot2c_f32_bf16 v80, v48, v97
  v_dot2c_f32_bf16 v81, v48, v73
  v_dot2c_f32_bf16 v82, v49, v97
  v_dot2c_f32_bf16 v83, v49, v73
  v_dot2c_f32_bf16 v84, v50, v97
  v_dot2c_f32_bf16 v85, v50, v73
  v_dot2c_f32_bf16 v86, v51, v97
  v_dot2c_f32_bf16 v87, v51, v73
  v_lshrrev_b32 v98, 16, v75
  s_waitcnt vmcnt(6)
  v_dot2c_f32_bf16 v80, v52, v98
  v_dot2c_f32_bf16 v81, v52, v75
  v_dot2c_f32_bf16 v82, v53, v98
  v_dot2c_f32_bf16 v83, v53, v75
  v_dot2c_f32_bf16 v84, v54, v98
  v_dot2c_f32_bf16 v85, v54, v75
  v_dot2c_f32_bf16 v86, v55, v98
  v_dot2c_f32_bf16 v87, v55, v75
  v_lshrrev_b32 v97, 16, v77
  s_waitcnt vmcnt(5)
  v_dot2c_f32_bf16 v80, v56, v97
  v_dot2c_f32_bf16 v81, v56, v77
  v_dot2c_f32_bf16 v82, v57, v97
  v_dot2c_f32_bf16 v83, v57, v77
  v_dot2c_f32_bf16 v84, v58, v97
  v_dot2c_f32_bf16 v85, v58, v77
  v_dot2c_f32_bf16 v86, v59, v97
  v_dot2c_f32_bf16 v87, v59, v77
  v_lshrrev_b32 v98, 16, v79
  s_waitcnt vmcnt(4)
  v_dot2c_f32_bf16 v80, v60, v98
  v_dot2c_f32_bf16 v81, v60, v79
  v_dot2c_f32_bf16 v82, v61, v98
  v_dot2c_f32_bf16 v83, v61, v79
  v_dot2c_f32_bf16 v84, v62, v98
  v_dot2c_f32_bf16 v85, v62, v79
  v_dot2c_f32_bf16 v86, v63, v98
  v_dot2c_f32_bf16 v87, v63, v79
  s_and_saveexec_b64 s[20:21], s[52:53]
  s_cbranch_execz L_k4_nf5
  s_cmp_eq_u32 s31, 0
  s_cbranch_scc1 L_k4_dw5
  ds_read_b128 v[120:123], v92
  ds_read_b128 v[124:127], v92 offset:16
  s_waitcnt lgkmcnt(0)
  v_add_f32 v80, v120, v80
  v_add_f32 v81, v121, v81
  v_add_f32 v82, v122, v82
  v_add_f32 v83, v123, v83
  v_add_f32 v84, v124, v84
  v_add_f32 v85, v125, v85
  v_add_f32 v86, v126, v86
  v_add_f32 v87, v127, v87
L_k4_dw5:
  ds_write_b128 v92, v[80:83]
  ds_write_b128 v92, v[84:87] offset:16
  s_nop 1
  v_mov_b32 v80, 0
  v_mov_b32 v81, 0
  v_mov_b32 v82, 0
  v_mov_b32 v83, 0
  v_mov_b32 v84, 0
  v_mov_b32 v85, 0
  v_mov_b32 v86, 0
  v_mov_b32 v87, 0
L_k4_nf5:
  s_mov_b64 exec, s[20:21]
  v_cmp_ne_u32 vcc, v99, v91
  s_cbranch_vccnz L_k4_loop
L_k4_gdone:
  s_waitcnt lgkmcnt(0)
  s_barrier
  s_mov_b32 s31, 1
  v_readfirstlane_b32 s23, v100
  v_readfirstlane_b32 s22, v101
  s_cmp_lg_u32 s22, 0
  s_cbranch_scc1 L_k4_iter
  s_add_u32 s27, s27, 32
  s_add_u32 s26, s26, 256
  s_cmp_lt_u32 s27, s23
  s_cbranch_scc1 L_k4_round
  s_cmp_ge_u32 s24, 13
  s_cbranch_scc1 L_k4_end
  v_lshlrev_b32 v8, 4, v5
  v_add_u32 v8, 129728, v8
  v_and_b32 v9, 15, v5
  s_lshl_b32 s29, s24, 4
  v_add_u32 v9, s29, v9
  v_lshrrev_b32 v10, 4, v5
  v_lshlrev_b32 v11, 7, v9
  s_waitcnt vmcnt(0)
  v_mov_b32 v16, v106
  v_mov_b32 v17, v107
  v_mov_b32 v18, v108
  v_mov_b32 v19, v109
  v_mov_b32 v20, v110
  v_mov_b32 v21, v111
  v_mov_b32 v22, v112
  v_mov_b32 v23, v113
  ds_read_b128 v[64:67], v8 offset:0
  ds_read_b128 v[68:71], v8 offset:1024
  ds_read_b128 v[72:75], v8 offset:2048
  ds_read_b128 v[76:79], v8 offset:3072
  ds_read_b128 v[80:83], v8 offset:4096
  ds_read_b128 v[84:87], v8 offset:5120
  ds_read_b128 v[88:91], v8 offset:6144
  ds_read_b128 v[92:95], v8 offset:7168
  ds_read_b128 v[96:99], v8 offset:8192
  ds_read_b128 v[100:103], v8 offset:9216
  ds_read_b128 v[104:107], v8 offset:10240
  ds_read_b128 v[108:111], v8 offset:11264
  ds_read_b128 v[112:115], v8 offset:12288
  ds_read_b128 v[116:119], v8 offset:13312
  ds_read_b128 v[120:123], v8 offset:14336
  ds_read_b128 v[124:127], v8 offset:15360
  v_lshlrev_b32 v13, 8, v9
  v_lshl_add_u32 v13, v10, 5, v13
  ds_read_b128 v[24:27], v13
  ds_read_b128 v[28:31], v13 offset:16
  ds_read_b128 v[32:35], v13 offset:128
  ds_read_b128 v[36:39], v13 offset:144
  s_waitcnt lgkmcnt(0)
  v_cvt_pk_bf16_f32 v40, v24, v25
  v_cvt_pk_bf16_f32 v41, v26, v27
  v_cvt_pk_bf16_f32 v42, v28, v29
  v_cvt_pk_bf16_f32 v43, v30, v31
  v_cvt_pk_bf16_f32 v44, v32, v33
  v_cvt_pk_bf16_f32 v45, v34, v35
  v_cvt_pk_bf16_f32 v46, v36, v37
  v_cvt_pk_bf16_f32 v47, v38, v39
  v_mov_b32 v48, 0
  v_mov_b32 v49, 0
  v_mov_b32 v50, 0
  v_mov_b32 v51, 0
  v_mov_b32 v52, 0
  v_mov_b32 v53, 0
  v_mov_b32 v54, 0
  v_mov_b32 v55, 0
  v_mov_b32 v56, 0
  v_mov_b32 v57, 0
  v_mov_b32 v58, 0
  v_mov_b32 v59, 0
  v_mov_b32 v60, 0
  v_mov_b32 v61, 0
  v_mov_b32 v62, 0
  v_mov_b32 v63, 0
  s_nop 1
  v_mfma_f32_16x16x32_bf16 v[48:51], v[64:67], v[16:19], v[48:51]
  v_mfma_f32_16x16x32_bf16 v[52:55], v[80:83], v[16:19], v[52:55]
  v_mfma_f32_16x16x32_bf16 v[56:59], v[96:99], v[16:19], v[56:59]
  v_mfma_f32_16x16x32_bf16 v[60:63], v[112:115], v[16:19], v[60:63]
  v_mfma_f32_16x16x32_bf16 v[48:51], v[68:71], v[20:23], v[48:51]
  v_mfma_f32_16x16x32_bf16 v[52:55], v[84:87], v[20:23], v[52:55]
  v_mfma_f32_16x16x32_bf16 v[56:59], v[100:103], v[20:23], v[56:59]
  v_mfma_f32_16x16x32_bf16 v[60:63], v[116:119], v[20:23], v[60:63]
  v_mfma_f32_16x16x32_bf16 v[48:51], v[72:75], v[40:43], v[48:51]
  v_mfma_f32_16x16x32_bf16 v[52:55], v[88:91], v[40:43], v[52:55]
  v_mfma_f32_16x16x32_bf16 v[56:59], v[104:107], v[40:43], v[56:59]
  v_mfma_f32_16x16x32_bf16 v[60:63], v[120:123], v[40:43], v[60:63]
  v_mfma_f32_16x16x32_bf16 v[48:51], v[76:79], v[44:47], v[48:51]
  v_mfma_f32_16x16x32_bf16 v[52:55], v[92:95], v[44:47], v[52:55]
  v_mfma_f32_16x16x32_bf16 v[56:59], v[108:111], v[44:47], v[56:59]
  v_mfma_f32_16x16x32_bf16 v[60:63], v[124:127], v[44:47], v[60:63]
  s_nop 7
  s_nop 7
  v_lshl_add_u32 v12, v10, 5, v11
  v_cmp_gt_u32 vcc, 200, v9
  s_and_saveexec_b64 s[20:21], vcc
  v_cvt_pk_bf16_f32 v24, v48, v49
  v_cvt_pk_bf16_f32 v25, v50, v51
  v_cvt_pk_bf16_f32 v26, v52, v53
  v_cvt_pk_bf16_f32 v27, v54, v55
  v_cvt_pk_bf16_f32 v28, v56, v57
  v_cvt_pk_bf16_f32 v29, v58, v59
  v_cvt_pk_bf16_f32 v30, v60, v61
  v_cvt_pk_bf16_f32 v31, v62, v63
  buffer_store_dwordx4 v[24:27], v12, s[12:15], s30 offen
  buffer_store_dwordx4 v[28:31], v12, s[12:15], s30 offen offset:16
L_k4_end:
  s_endpgm
.section .rodata,"a"
.p2align 6
.amdhsa_kernel k1_sort_kernel
  .amdhsa_next_free_vgpr 64
  .amdhsa_next_free_sgpr 80
  .amdhsa_accum_offset 64
  .amdhsa_group_segment_fixed_size 0
  .amdhsa_kernarg_size 64
  .amdhsa_user_sgpr_count 2
  .amdhsa_user_sgpr_kernarg_segment_ptr 1
  .amdhsa_system_sgpr_workgroup_id_x 1
.end_amdhsa_kernel
.p2align 6
.amdhsa_kernel k4_main_kernel
  .amdhsa_next_free_vgpr 128
  .amdhsa_next_free_sgpr 80
  .amdhsa_accum_offset 128
  .amdhsa_group_segment_fixed_size 0
  .amdhsa_kernarg_size 64
  .amdhsa_user_sgpr_count 2
  .amdhsa_user_sgpr_kernarg_segment_ptr 1
  .amdhsa_system_sgpr_workgroup_id_x 1
.end_amdhsa_kernel
```
